```python
import torch

def _softmax(x, axis=-1):
    return torch.softmax(x, dim=axis)
def _gelu(x):
    return torch.nn.functional.gelu(x, approximate="tanh")
def _silu(x):
    return torch.nn.functional.silu(x)
def _sigmoid(x):
    return torch.sigmoid(x)
def _layernorm(x, axis=-1, eps=1e-5):
    m = x.mean(dim=axis, keepdim=True)
    v = x.var(dim=axis, keepdim=True, unbiased=False)
    return (x - m) / torch.sqrt(v + eps)
def _scatter_add(tgt, idx, src, axis=0):
    return tgt.clone().index_add_(axis, idx, src)
def _segment_sum(src, seg, n):
    out = torch.zeros((n,) + src.shape[1:], dtype=src.dtype)
    return out.index_add_(0, seg, src)
def _pad(x, pw):
    flat = tuple(v for pair in reversed(pw) for v in pair)
    return torch.nn.functional.pad(x, flat)

kernel_name = 'standalone__gqa_softmax__sampling'

def setup_inputs():

    _w = (lambda a: (lambda t: t.to(torch.bfloat16) if t.is_floating_point() else t)(torch.as_tensor(a)))
    B, Hq, Hkv, Sq, Sk, D = 8, 32, 32, 16, 2048, 128
    return {
        "q": _w((lambda *s: torch.randn(*s, dtype=torch.bfloat16) * 0.8)(B, Hq, Sq, D)),
        "k": _w((lambda *s: torch.randn(*s, dtype=torch.bfloat16) * 0.8)(B, Hkv, Sk, D)),
        "v": _w((lambda *s: torch.randn(*s, dtype=torch.bfloat16) * 0.05)(B, Hkv, Sk, D)),
    }

def reference(q, k, v):
    B, Hq, Sq, D = q.shape
    Hkv = k.shape[1]
    rep = Hq // Hkv
    k = (lambda x, n, axis: torch.repeat_interleave(x, n, dim=axis))(k, rep, axis=1)
    v = (lambda x, n, axis: torch.repeat_interleave(x, n, dim=axis))(v, rep, axis=1)
    scale = D ** -0.5
    scores = torch.einsum("bhqd,bhkd->bhqk", q, k) * scale
    p = _softmax(scores, axis=-1)
    return torch.einsum("bhqk,bhkd->bhqd", p, v)
```

```asm
; @launch grid=(256,1,1) block=(384,1,1) lds=144896
.amdgcn_target "amdgcn-amd-amdhsa--gfx950"
.text
.globl standalone__gqa_softmax__sampling_kernel
.p2align 12
.p2align 8
.type standalone__gqa_softmax__sampling_kernel,@function
standalone__gqa_softmax__sampling_kernel:
    s_load_dwordx2 s[12:13], s[0:1], 8
    s_load_dwordx8 s[4:11], s[0:1], 0
    s_cmpk_ge_u32 s2, 256
    s_cbranch_scc1 L_end
    v_readfirstlane_b32 s3, v0
    v_and_b32 v1, 63, v0
    s_cmpk_eq_u32 s3, 320
    s_cbranch_scc1 L_bal
    v_lshlrev_b32 v2, 4, v1
    v_and_b32 v3, 48, v1
    v_lshlrev_b32 v3, 1, v3
    v_xor_b32 v2, v2, v3
    s_and_b32 s28, s2, 7
    s_lshl_b32 s28, s28, 2
    s_bfe_u32 s29, s2, 0x20003
    s_or_b32 s28, s28, s29
    s_lshr_b32 s27, s2, 5
    s_lshl_b32 s26, s27, 5
    s_or_b32 s28, s28, s26
    s_mov_b32 s15, 0x20000
    s_cmp_lg_u32 s3, 0
    s_cbranch_scc1 L_other
    s_load_dwordx2 s[24:25], s[0:1], 0
    s_setprio 3
    s_lshl_b32 s28, s28, 19
    s_lshl_b32 s27, s27, 12
    s_lshl_b32 s29, s29, 17
    s_or_b32 s27, s27, s29
    s_or_b32 s27, s27, s28
    s_bitcmp1_b32 s2, 7
    s_movk_i32 s18, 0x1000
    s_cselect_b32 s18, 0x3000, s18
    s_or_b32 s19, s18, 0x8000
    s_mov_b32 s14, 0x8000000
    s_mov_b32 s22, 0
    s_mov_b32 s36, 0
    s_mov_b32 s23, 0
    v_mov_b32 v7, 139520
    v_xor_b32 v8, 0x80, v2
    s_mov_b32 s16, s27
    s_mov_b32 s37, s27
    s_lshr_b32 s17, s28, 7
    s_mov_b32 s26, 0x100000
    s_mov_b32 s27, 0x20000
    s_mov_b32 m0, 135168
    s_waitcnt lgkmcnt(0)
    buffer_load_dwordx4 v2, s[24:27], s17 offen offset:0 nt lds
    buffer_load_dwordx4 v8, s[24:27], s17 offen offset:1024 nt lds
    buffer_load_dwordx4 v2, s[24:27], s17 offen offset:2048 nt lds
    buffer_load_dwordx4 v8, s[24:27], s17 offen offset:3072 nt lds
    s_mov_b32 m0, 0
    s_nop 0
L_free:
    buffer_load_dwordx4 v2, s[12:15], s16 offen offset:0 nt lds
    buffer_load_dwordx4 v8, s[12:15], s16 offen offset:1024 nt lds
    buffer_load_dwordx4 v2, s[12:15], s16 offen offset:2048 nt lds
    buffer_load_dwordx4 v8, s[12:15], s16 offen offset:3072 nt lds
    s_add_u32 m0, s22, 0x1000
    s_xor_b32 s17, s16, 0x8000
    buffer_load_dwordx4 v2, s[12:15], s17 offen offset:0 nt lds
    buffer_load_dwordx4 v8, s[12:15], s17 offen offset:1024 nt lds
    buffer_load_dwordx4 v2, s[12:15], s17 offen offset:2048 nt lds
    buffer_load_dwordx4 v8, s[12:15], s17 offen offset:3072 nt lds
    s_add_u32 m0, s22, 0x2000
    s_xor_b32 s17, s16, s18
    buffer_load_dwordx4 v2, s[12:15], s17 offen offset:0 nt lds
    buffer_load_dwordx4 v8, s[12:15], s17 offen offset:1024 nt lds
    buffer_load_dwordx4 v2, s[12:15], s17 offen offset:2048 nt lds
    buffer_load_dwordx4 v8, s[12:15], s17 offen offset:3072 nt lds
    s_add_u32 m0, s22, 0x3000
    s_xor_b32 s17, s16, s19
    buffer_load_dwordx4 v2, s[12:15], s17 offen offset:0 nt lds
    buffer_load_dwordx4 v8, s[12:15], s17 offen offset:1024 nt lds
    buffer_load_dwordx4 v2, s[12:15], s17 offen offset:2048 nt lds
    buffer_load_dwordx4 v8, s[12:15], s17 offen offset:3072 nt lds
    s_cmp_lg_u32 s23, 0
    s_cbranch_scc1 L_drain
    s_movk_i32 s22, 0x4000
    s_movk_i32 s36, 0x2000
    s_mov_b32 s23, 1
    s_mov_b32 m0, s22
    s_xor_b32 s16, s36, s37
L_hi:
    s_waitcnt vmcnt(19)
    buffer_load_dwordx4 v2, s[12:15], s16 offen offset:0 nt lds
    buffer_load_dwordx4 v8, s[12:15], s16 offen offset:1024 nt lds
    s_waitcnt vmcnt(19)
    buffer_load_dwordx4 v2, s[12:15], s16 offen offset:2048 nt lds
    buffer_load_dwordx4 v8, s[12:15], s16 offen offset:3072 nt lds
    s_add_u32 m0, s22, 0x1000
    s_xor_b32 s17, s16, 0x8000
    s_waitcnt vmcnt(19)
    buffer_load_dwordx4 v2, s[12:15], s17 offen offset:0 nt lds
    buffer_load_dwordx4 v8, s[12:15], s17 offen offset:1024 nt lds
    s_waitcnt vmcnt(19)
    buffer_load_dwordx4 v2, s[12:15], s17 offen offset:2048 nt lds
    buffer_load_dwordx4 v8, s[12:15], s17 offen offset:3072 nt lds
    s_cmp_eq_u32 s23, 41
    s_cbranch_scc1 L_xh
L_xbh:
    s_add_u32 m0, s22, 0x2000
    s_xor_b32 s17, s16, s18
    s_waitcnt vmcnt(19)
    buffer_load_dwordx4 v2, s[12:15], s17 offen offset:0 nt lds
    buffer_load_dwordx4 v8, s[12:15], s17 offen offset:1024 nt lds
    s_waitcnt vmcnt(19)
    buffer_load_dwordx4 v2, s[12:15], s17 offen offset:2048 nt lds
    buffer_load_dwordx4 v8, s[12:15], s17 offen offset:3072 nt lds
    s_add_u32 m0, s22, 0x3000
    s_xor_b32 s17, s16, s19
    s_waitcnt vmcnt(19)
    buffer_load_dwordx4 v2, s[12:15], s17 offen offset:0 nt lds
    buffer_load_dwordx4 v8, s[12:15], s17 offen offset:1024 nt lds
    s_waitcnt vmcnt(19)
    buffer_load_dwordx4 v2, s[12:15], s17 offen offset:2048 nt lds
    buffer_load_dwordx4 v8, s[12:15], s17 offen offset:3072 nt lds
    s_branch L_tail
L_lo:
    s_waitcnt vmcnt(16)
    buffer_load_dwordx4 v2, s[12:15], s16 offen offset:0 nt lds
    buffer_load_dwordx4 v8, s[12:15], s16 offen offset:1024 nt lds
    s_waitcnt vmcnt(16)
    buffer_load_dwordx4 v2, s[12:15], s16 offen offset:2048 nt lds
    buffer_load_dwordx4 v8, s[12:15], s16 offen offset:3072 nt lds
    s_add_u32 m0, s22, 0x1000
    s_xor_b32 s17, s16, 0x8000
    s_waitcnt vmcnt(16)
    buffer_load_dwordx4 v2, s[12:15], s17 offen offset:0 nt lds
    buffer_load_dwordx4 v8, s[12:15], s17 offen offset:1024 nt lds
    s_waitcnt vmcnt(16)
    buffer_load_dwordx4 v2, s[12:15], s17 offen offset:2048 nt lds
    buffer_load_dwordx4 v8, s[12:15], s17 offen offset:3072 nt lds
    s_cmp_eq_u32 s23, 41
    s_cbranch_scc1 L_xl
L_xbl:
    s_add_u32 m0, s22, 0x2000
    s_xor_b32 s17, s16, s18
    s_waitcnt vmcnt(16)
    buffer_load_dwordx4 v2, s[12:15], s17 offen offset:0 nt lds
    buffer_load_dwordx4 v8, s[12:15], s17 offen offset:1024 nt lds
    s_waitcnt vmcnt(16)
    buffer_load_dwordx4 v2, s[12:15], s17 offen offset:2048 nt lds
    buffer_load_dwordx4 v8, s[12:15], s17 offen offset:3072 nt lds
    s_add_u32 m0, s22, 0x3000
    s_xor_b32 s17, s16, s19
    s_waitcnt vmcnt(16)
    buffer_load_dwordx4 v2, s[12:15], s17 offen offset:0 nt lds
    buffer_load_dwordx4 v8, s[12:15], s17 offen offset:1024 nt lds
    s_waitcnt vmcnt(16)
    buffer_load_dwordx4 v2, s[12:15], s17 offen offset:2048 nt lds
    buffer_load_dwordx4 v8, s[12:15], s17 offen offset:3072 nt lds
L_tail:
    s_barrier
    ds_read_b32 v14, v7
    s_add_u32 s22, s22, 0x4000
    s_and_b32 s22, s22, 0x1ffff
    s_or_b32 s36, s36, 0xfff89fff
    s_add_u32 s36, s36, 1
    s_and_b32 s36, s36, 0x76000
    s_mov_b32 m0, s22
    s_xor_b32 s16, s36, s37
    s_add_u32 s23, s23, 1
    s_cmp_eq_u32 s23, 32
    s_cselect_b32 s12, s8, s12
    s_cselect_b32 s13, s9, s13
    s_cmp_eq_u32 s23, 63
    s_cbranch_scc1 L_free
    s_waitcnt lgkmcnt(0)
    v_readfirstlane_b32 s33, v14
    s_nop 0
    s_cmp_eq_u32 s33, 1
    s_cbranch_scc1 L_lo
    s_cmp_eq_u32 s33, 0
    s_cbranch_scc1 L_hi
L_bo:
    s_waitcnt vmcnt(24)
    buffer_load_dwordx4 v2, s[12:15], s16 offen offset:0 nt lds
    buffer_load_dwordx4 v8, s[12:15], s16 offen offset:1024 nt lds
    s_waitcnt vmcnt(24)
    buffer_load_dwordx4 v2, s[12:15], s16 offen offset:2048 nt lds
    buffer_load_dwordx4 v8, s[12:15], s16 offen offset:3072 nt lds
    s_add_u32 m0, s22, 0x1000
    s_xor_b32 s17, s16, 0x8000
    s_waitcnt vmcnt(24)
    buffer_load_dwordx4 v2, s[12:15], s17 offen offset:0 nt lds
    buffer_load_dwordx4 v8, s[12:15], s17 offen offset:1024 nt lds
    s_waitcnt vmcnt(24)
    buffer_load_dwordx4 v2, s[12:15], s17 offen offset:2048 nt lds
    buffer_load_dwordx4 v8, s[12:15], s17 offen offset:3072 nt lds
    s_cmp_eq_u32 s23, 41
    s_cbranch_scc1 L_xb
L_xbb:
    s_add_u32 m0, s22, 0x2000
    s_xor_b32 s17, s16, s18
    s_waitcnt vmcnt(24)
    buffer_load_dwordx4 v2, s[12:15], s17 offen offset:0 nt lds
    buffer_load_dwordx4 v8, s[12:15], s17 offen offset:1024 nt lds
    s_waitcnt vmcnt(24)
    buffer_load_dwordx4 v2, s[12:15], s17 offen offset:2048 nt lds
    buffer_load_dwordx4 v8, s[12:15], s17 offen offset:3072 nt lds
    s_add_u32 m0, s22, 0x3000
    s_xor_b32 s17, s16, s19
    s_waitcnt vmcnt(24)
    buffer_load_dwordx4 v2, s[12:15], s17 offen offset:0 nt lds
    buffer_load_dwordx4 v8, s[12:15], s17 offen offset:1024 nt lds
    s_waitcnt vmcnt(24)
    buffer_load_dwordx4 v2, s[12:15], s17 offen offset:2048 nt lds
    buffer_load_dwordx4 v8, s[12:15], s17 offen offset:3072 nt lds
    s_branch L_tail
L_drain:
    s_waitcnt vmcnt(32)
    s_barrier
    s_waitcnt vmcnt(16)
    s_barrier
    s_waitcnt vmcnt(0)
    s_barrier
    s_endpgm
L_xh:
    s_barrier
    s_branch L_xbh
L_xl:
    s_barrier
    s_branch L_xbl
L_xb:
    s_barrier
    s_branch L_xbb
L_other:
    s_lshr_b32 s3, s3, 6
    s_sub_u32 s3, s3, 1
    s_lshl_b32 s29, s28, 12
    s_movk_i32 s26, 0x1000
    s_mov_b32 s27, 0x20000
    s_waitcnt lgkmcnt(0)
    s_add_u32 s24, s10, s29
    s_addc_u32 s25, s11, 0
    v_and_b32 v3, 15, v1
    v_lshrrev_b32 v14, 4, v1
    v_and_b32 v13, 7, v1
    v_lshlrev_b32 v13, 1, v13
    v_xor_b32 v13, v13, v14
    v_lshlrev_b32 v13, 4, v13
    v_lshl_add_u32 v4, v3, 8, v13
    s_mul_i32 s31, s3, 1280
    s_add_u32 s31, s31, 139776
    v_mul_u32_u24 v13, 80, v3
    v_lshl_add_u32 v13, v14, 3, v13
    v_add_u32 v0, s31, v13
    v_lshrrev_b32 v13, 2, v1
    v_and_b32 v14, 3, v1
    v_lshlrev_b32 v14, 4, v14
    v_lshl_add_u32 v12, v13, 8, v14
    v_mul_u32_u24 v13, 80, v13
    v_add3_u32 v2, v13, v14, s31
    s_lshl_b32 s31, s3, 6
    v_add_u32 v12, s31, v12
    v_lshlrev_b32 v15, 4, v3
    v_add_u32 v15, 139264, v15
    v_add_u32 v16, 135168, v4
    v_xor_b32 v17, 64, v16
    v_xor_b32 v18, 128, v16
    v_xor_b32 v19, 192, v16
    s_lshl_b32 s31, s3, 12
    v_add_u32 v4, s31, v4
    v_xor_b32 v5, 64, v4
    v_xor_b32 v6, 128, v4
    v_xor_b32 v7, 192, v4
    v_lshrrev_b32 v3, 2, v1
    v_and_b32 v13, 7, v3
    v_lshlrev_b32 v13, 1, v13
    s_lshl_b32 s31, s3, 2
    v_xor_b32 v13, s31, v13
    v_lshlrev_b32 v13, 4, v13
    v_lshl_add_u32 v8, v3, 8, v13
    v_and_b32 v13, 3, v1
    v_lshl_add_u32 v8, v13, 3, v8
    v_xor_b32 v13, 32, v8
    v_lshlrev_b32 v10, 4, v1
    v_add_u32 v10, 131072, v10
    s_lshr_b32 s31, s3, 1
    s_lshl_b32 s31, s31, 10
    s_and_b32 s30, s3, 1
    s_lshl_b32 s30, s30, 3
    s_add_u32 s31, s31, s30
    v_add_u32 v9, s31, v10
    v_mov_b32 v11, 0xff800000
    v_mov_b32 v72, 0x3f803f80
    v_mov_b32 v73, v72
    v_mov_b32 v74, v72
    v_mov_b32 v75, v72
    v_mov_b32 v60, 0
    v_mov_b32 v61, 0
    v_mov_b32 v62, 0
    v_mov_b32 v63, 0
    v_mov_b32 v64, 0
    v_mov_b32 v65, 0
    v_mov_b32 v66, 0
    v_mov_b32 v67, 0
    v_mov_b32 v68, 0
    v_mov_b32 v69, 0
    v_mov_b32 v70, 0
    v_mov_b32 v71, 0
    s_mov_b32 s32, 0x3e0293ee
    s_mov_b32 s33, 0
    s_barrier
    s_barrier
    ds_read_b128 v[44:47], v16
    ds_read_b128 v[48:51], v17
    ds_read_b128 v[52:55], v18
    ds_read_b128 v[56:59], v19
    s_branch L_k1
L_k:
    s_barrier
L_k1:
    ds_read_b128 v[20:23], v4
    ds_read_b128 v[24:27], v5
    ds_read_b128 v[28:31], v6
    ds_read_b128 v[32:35], v7
    v_add_u32 v4, 0x4000, v4
    v_and_b32 v4, 0x1ffff, v4
    v_xor_b32 v5, 64, v4
    v_xor_b32 v6, 128, v4
    v_xor_b32 v7, 192, v4
    s_waitcnt lgkmcnt(3)
    v_mfma_f32_16x16x32_bf16 v[16:19], v[20:23], v[44:47], 0
    s_waitcnt lgkmcnt(2)
    v_mfma_f32_16x16x32_bf16 v[16:19], v[24:27], v[48:51], v[16:19]
    s_waitcnt lgkmcnt(1)
    v_mfma_f32_16x16x32_bf16 v[16:19], v[28:31], v[52:55], v[16:19]
    s_waitcnt lgkmcnt(0)
    v_mfma_f32_16x16x32_bf16 v[16:19], v[32:35], v[56:59], v[16:19]
    s_nop 7
    v_max3_f32 v11, v11, v16, v17
    v_max3_f32 v11, v11, v18, v19
    s_set_gpr_idx_on s33, gpr_idx(DST)
    v_mov_b32 v76, v16
    v_mov_b32 v77, v17
    v_mov_b32 v78, v18
    v_mov_b32 v79, v19
    s_set_gpr_idx_off
    s_add_u32 s33, s33, 4
    s_cmpk_lt_u32 s33, 128
    s_cbranch_scc1 L_k
    v_mov_b32 v3, v11
    s_lshl_b32 s31, s3, 2
    v_add_u32 v14, s31, v15
    v_permlane32_swap_b32 v11, v3
    s_nop 0
    v_max_f32 v11, v11, v3
    v_mov_b32 v3, v11
    s_nop 1
    v_permlane16_swap_b32 v11, v3
    s_nop 0
    v_max_f32 v11, v11, v3
    ds_write_b32 v14, v11
    s_mov_b32 s33, 0
    s_waitcnt lgkmcnt(0)
    s_barrier
    ds_read_b128 v[16:19], v15
    s_waitcnt lgkmcnt(0)
    v_max3_f32 v11, v16, v17, v18
    v_max_f32 v11, v11, v19
    v_mul_f32 v11, s32, v11
L_v:
    s_set_gpr_idx_on s33, gpr_idx(SRC0)
    v_fma_f32 v16, v76, s32, -v11
    v_fma_f32 v17, v77, s32, -v11
    v_fma_f32 v18, v78, s32, -v11
    v_fma_f32 v19, v79, s32, -v11
    s_set_gpr_idx_off
    v_exp_f32 v16, v16
    v_exp_f32 v17, v17
    v_exp_f32 v18, v18
    v_exp_f32 v19, v19
    s_add_u32 s33, s33, 4
    v_cvt_pk_bf16_f32 v16, v16, v17
    v_cvt_pk_bf16_f32 v17, v18, v19
    ds_write_b64 v9, v[16:17]
    v_xor_b32 v9, 0x800, v9
    s_cmpk_lt_u32 s33, 128
    s_waitcnt lgkmcnt(0)
    s_barrier
    ds_read_b128 v[36:39], v10 offset:0
    ds_read_b128 v[40:43], v10 offset:1024
    ds_read_b64_tr_b16 v[20:21], v8 offset:0
    ds_read_b64_tr_b16 v[22:23], v8 offset:4096
    ds_read_b64_tr_b16 v[24:25], v13 offset:0
    ds_read_b64_tr_b16 v[26:27], v13 offset:4096
    ds_read_b64_tr_b16 v[28:29], v8 offset:8192
    ds_read_b64_tr_b16 v[30:31], v8 offset:12288
    ds_read_b64_tr_b16 v[32:33], v13 offset:8192
    ds_read_b64_tr_b16 v[34:35], v13 offset:12288
    s_waitcnt lgkmcnt(8)
    v_mfma_f32_16x16x32_bf16 v[68:71], v[72:75], v[36:39], v[68:71]
    v_xor_b32 v10, 0x800, v10
    s_waitcnt lgkmcnt(6)
    v_mfma_f32_16x16x32_bf16 v[60:63], v[20:23], v[36:39], v[60:63]
    v_add_u32 v8, 0x4000, v8
    v_mfma_f32_16x16x32_bf16 v[68:71], v[72:75], v[40:43], v[68:71]
    s_waitcnt lgkmcnt(4)
    v_mfma_f32_16x16x32_bf16 v[64:67], v[24:27], v[36:39], v[64:67]
    v_and_b32 v8, 0x1ffff, v8
    s_waitcnt lgkmcnt(2)
    v_mfma_f32_16x16x32_bf16 v[60:63], v[28:31], v[40:43], v[60:63]
    v_xor_b32 v13, 32, v8
    s_waitcnt lgkmcnt(0)
    v_mfma_f32_16x16x32_bf16 v[64:67], v[32:35], v[40:43], v[64:67]
    s_cbranch_scc1 L_v
    v_rcp_f32 v14, v68
    s_nop 2
    v_pk_mul_f32 v[60:61], v[60:61], v[14:15] op_sel_hi:[1,0]
    v_pk_mul_f32 v[62:63], v[62:63], v[14:15] op_sel_hi:[1,0]
    v_cvt_pk_bf16_f32 v16, v60, v61
    v_cvt_pk_bf16_f32 v17, v62, v63
    ds_write_b64 v0, v[16:17] offset:0
    v_pk_mul_f32 v[64:65], v[64:65], v[14:15] op_sel_hi:[1,0]
    v_pk_mul_f32 v[66:67], v[66:67], v[14:15] op_sel_hi:[1,0]
    v_cvt_pk_bf16_f32 v18, v64, v65
    v_cvt_pk_bf16_f32 v19, v66, v67
    ds_write_b64 v0, v[18:19] offset:32
    ds_read_b128 v[20:23], v2
    s_waitcnt lgkmcnt(0)
    buffer_store_dwordx4 v[20:23], v12, s[24:27], 0 offen
    s_endpgm
L_bal:
    s_load_dwordx2 s[16:17], s[0:1], 32
    s_load_dwordx2 s[34:35], s[0:1], 40
    s_and_b32 s20, s2, 7
    s_lshl_b32 s20, s20, 5
    v_mov_b32 v6, s20
    s_lshr_b32 s21, s2, 3
    s_add_u32 s20, s20, s21
    v_mov_b32 v4, s20
    v_mov_b32 v5, 1
    v_mov_b32 v7, 139520
    v_mov_b32 v14, 0
    ds_write_b32 v7, v14
    v_mov_b32 v15, 24
    s_movk_i32 s18, 0x100
    s_mov_b32 s19, 0x20000
    s_mov_b32 s23, 0
    s_mov_b32 s24, 0
    s_mov_b32 s25, 0
    s_mov_b32 s26, 0
    v_mul_u32_u24 v8, 4352, v1
    s_waitcnt lgkmcnt(0)
    s_cmp_lg_u32 s21, 0
    s_cbranch_scc1 L_bnl
    s_mov_b32 s24, 10
    s_mov_b32 exec_hi, 0
    global_load_dword v9, v8, s[34:35]
L_bnl:
    v_add_u32 v10, s24, v5
    s_mov_b64 exec, 1
    s_waitcnt lgkmcnt(0)
    s_barrier
    buffer_load_dwordx4 v[16:19], v6, s[16:19], 0 offen nt
    buffer_load_dwordx4 v[20:23], v6, s[16:19], 0 offen offset:16 nt
    buffer_store_byte v10, v4, s[16:19], 0 offen
L_bl:
    v_add_u32 v5, 1, v5
    v_add_u32 v10, s24, v5
    s_barrier
    buffer_load_dwordx4 v[24:27], v6, s[16:19], 0 offen nt
    buffer_load_dwordx4 v[28:31], v6, s[16:19], 0 offen offset:16 nt
    buffer_store_byte v10, v4, s[16:19], 0 offen
    s_cmp_eq_u32 s23, 38
    s_cbranch_scc0 L_bnx
    s_barrier
L_bnx:
    s_waitcnt vmcnt(3)
    v_sad_u8 v14, v16, 0, 0
    v_sad_u8 v14, v17, 0, v14
    v_sad_u8 v14, v18, 0, v14
    v_sad_u8 v14, v19, 0, v14
    v_sad_u8 v14, v20, 0, v14
    v_sad_u8 v14, v21, 0, v14
    v_sad_u8 v14, v22, 0, v14
    v_sad_u8 v14, v23, 0, v14
    v_cmp_le_u32 vcc, v14, v15
    v_add_u32 v15, 32, v15
    s_add_u32 s23, s23, 1
    v_cndmask_b32 v13, 0, 1, vcc
    v_add_u32 v14, 11, v14
    v_cmp_gt_u32 vcc, v14, v15
    s_nop 1
    v_cndmask_b32 v14, v13, 2, vcc
    ds_write_b32 v7, v14
    v_add_u32 v5, 1, v5
    v_add_u32 v10, s24, v5
    s_barrier
    buffer_load_dwordx4 v[16:19], v6, s[16:19], 0 offen nt
    buffer_load_dwordx4 v[20:23], v6, s[16:19], 0 offen offset:16 nt
    buffer_store_byte v10, v4, s[16:19], 0 offen
    s_cmp_lg_u32 s21, 0
    s_cbranch_scc1 L_bn2
    s_waitcnt lgkmcnt(0)
    s_mov_b32 s37, s26
    s_mov_b32 s26, 1
    s_atomic_add s26, s[34:35], s25 glc
    s_add_u32 s25, s25, 4352
    s_cmp_lt_u32 s23, 2
    s_cbranch_scc1 L_bn2
    s_lshr_b32 s27, s23, 1
    s_sub_u32 s27, s27, 1
    v_readlane_b32 s27, v9, s27
    s_nop 0
    s_sub_u32 s37, s37, s27
    s_min_u32 s37, s37, 7
    s_mul_i32 s24, s37, 3
    s_cmp_ge_u32 s23, 55
    s_cselect_b32 s21, 1, s21
L_bn2:
    s_waitcnt vmcnt(3)
    v_sad_u8 v14, v24, 0, 0
    v_sad_u8 v14, v25, 0, v14
    v_sad_u8 v14, v26, 0, v14
    v_sad_u8 v14, v27, 0, v14
    v_sad_u8 v14, v28, 0, v14
    v_sad_u8 v14, v29, 0, v14
    v_sad_u8 v14, v30, 0, v14
    v_sad_u8 v14, v31, 0, v14
    v_cmp_le_u32 vcc, v14, v15
    v_add_u32 v15, 32, v15
    s_add_u32 s23, s23, 1
    v_cndmask_b32 v13, 0, 1, vcc
    v_add_u32 v14, 11, v14
    v_cmp_gt_u32 vcc, v14, v15
    s_nop 1
    v_cndmask_b32 v14, v13, 2, vcc
    ds_write_b32 v7, v14
    s_cmp_lt_u32 s23, 60
    s_cbranch_scc1 L_bl
    s_barrier
L_end:
    s_endpgm
.section .rodata,"a"
.p2align 6
.amdhsa_kernel standalone__gqa_softmax__sampling_kernel
  .amdhsa_next_free_vgpr 204
  .amdhsa_next_free_sgpr 40
  .amdhsa_accum_offset 204
  .amdhsa_group_segment_fixed_size 0
  .amdhsa_kernarg_size 48
  .amdhsa_user_sgpr_count 2
  .amdhsa_user_sgpr_kernarg_segment_ptr 1
  .amdhsa_system_sgpr_workgroup_id_x 1
.end_amdhsa_kernel
```
